```python
import torch

def _softmax(x, axis=-1):
    return torch.softmax(x, dim=axis)
def _gelu(x):
    return torch.nn.functional.gelu(x, approximate="tanh")
def _silu(x):
    return torch.nn.functional.silu(x)
def _sigmoid(x):
    return torch.sigmoid(x)
def _layernorm(x, axis=-1, eps=1e-5):
    m = x.mean(dim=axis, keepdim=True)
    v = x.var(dim=axis, keepdim=True, unbiased=False)
    return (x - m) / torch.sqrt(v + eps)
def _scatter_add(tgt, idx, src, axis=0):
    return tgt.clone().index_add_(axis, idx, src)
def _segment_sum(src, seg, n):
    out = torch.zeros((n,) + src.shape[1:], dtype=src.dtype)
    return out.index_add_(0, seg, src)
def _pad(x, pw):
    flat = tuple(v for pair in reversed(pw) for v in pair)
    return torch.nn.functional.pad(x, flat)

kernel_name = 'standalone__linear_kernel_rfa__prompt'

def setup_inputs():

    _w = (lambda a: (lambda t: t.to(torch.bfloat16) if t.is_floating_point() else t)(torch.as_tensor(a)))
    B, H, Sq, Sk, D, M = 1, 16, 2048, 2048, 256, 8
    return {
        "q": _w((lambda *s: torch.randn(*s, dtype=torch.bfloat16) * 0.1)(B, H, Sq, D)),
        "k": _w((lambda *s: torch.randn(*s, dtype=torch.bfloat16) * 1.6)(B, H, Sk, D)),
        "v": _w((lambda *s: torch.randn(*s, dtype=torch.bfloat16) * 1.6)(B, H, Sk, D)),
        "omega": _w((lambda *s: torch.randn(*s, dtype=torch.bfloat16) * 1.6)(M, D)),
    }

def reference(q, k, v, omega):
    d = q.shape[-1]
    m = omega.shape[0]
    scale = float(d) ** -0.25
    qs = q * scale
    ks = k * scale
    q_proj = torch.einsum("bhsd,md->bhsm", qs, omega)
    k_proj = torch.einsum("bhsd,md->bhsm", ks, omega)
    q_sq = 0.5 * torch.einsum("bhsd,bhsd->bhs", qs, qs)[..., None]
    k_sq = 0.5 * torch.einsum("bhsd,bhsd->bhs", ks, ks)[..., None]
    inv_sqrt_m = float(m) ** -0.5
    phi_q = torch.exp(q_proj - q_sq) * inv_sqrt_m + 1e-6
    phi_k = torch.exp(k_proj - k_sq) * inv_sqrt_m + 1e-6
    kv = torch.einsum("bhsm,bhsd->bhmd", phi_k, v)
    z  = torch.einsum("bhsm->bhm", phi_k)
    num = torch.einsum("bhqm,bhmd->bhqd", phi_q, kv)
    den = torch.einsum("bhqm,bhm->bhq", phi_q, z)[..., None] + 1e-6
    return num / den
```

```asm
; @launch grid=(256,1,1) block=(512,1,1) lds=147648
.amdgcn_target "amdgcn-amd-amdhsa--gfx950"
.text
.p2align 8
.globl standalone__linear_kernel_rfa__prompt_kernel
.type standalone__linear_kernel_rfa__prompt_kernel,@function
standalone__linear_kernel_rfa__prompt_kernel:
s_cmp_ge_u32 s2, 256
s_cbranch_scc1 L_end
s_load_dwordx8 s[4:11], s[0:1], 0
s_load_dwordx2 s[12:13], s[0:1], 32
s_load_dwordx2 s[16:17], s[0:1], 48
s_load_dwordx2 s[92:93], s[0:1], 40
v_lshrrev_b32 v5, 6, v0
v_bfe_u32 v1, v0, 5, 1
v_and_b32 v2, 31, v0
v_readfirstlane_b32 s48, v5
s_and_b32 s51, s2, 7
s_lshl_b32 s51, s51, 5
s_lshr_b32 s69, s2, 3
s_or_b32 s69, s69, s51
v_xor_b32 v5, v2, v1
v_lshlrev_b32 v5, 4, v5
v_lshl_add_u32 v8, v1, 9, v5
s_lshl_b32 s60, s69, 16
s_lshl_b32 s65, s48, 13
s_add_u32 s66, s65, 4096
s_mov_b32 s26, 65536
s_mov_b32 s27, 0x20000
s_mov_b32 m0, s65
v_xor_b32 v9, 32, v8
v_xor_b32 v10, 64, v8
v_xor_b32 v11, 96, v8
s_mov_b32 s94, 256
s_mov_b32 s95, 0x20000
s_cmp_ge_u32 s48, 4
s_waitcnt lgkmcnt(0)
s_getreg_b32 s1, hwreg(HW_REG_XCC_ID, 0, 4)
s_cbranch_scc1 L_omega
s_cmp_lg_u32 s48, 0
s_cbranch_scc1 L_kload
s_add_u32 s51, s1, 1
v_mov_b32 v6, s51
s_mov_b64 exec, 1
buffer_store_byte v6, off, s[92:95], s69
s_mov_b64 exec, -1
s_branch L_kload
L_omega:
s_and_b32 s61, s48, 3
s_lshl_b32 s51, s61, 2
s_lshl_b32 s61, s61, 10
v_lshlrev_b32 v5, 1, v1
v_xor_b32 v5, v5, v2
v_xor_b32 v5, s51, v5
v_lshlrev_b32 v5, 4, v5
v_lshl_add_u32 v7, v1, 9, v5
s_add_u32 m0, s61, 131072
s_mov_b32 s32, s10
s_mov_b32 s33, s11
s_mov_b32 s34, 4096
s_mov_b32 s35, 0x20000
buffer_load_dwordx4 v7, s[32:35], s61 offen lds
s_mov_b32 m0, s65
L_kload:
s_add_u32 s24, s6, s60
s_addc_u32 s25, s7, 0
buffer_load_dwordx4 v8, s[24:27], s65 offen offset:0 nt lds
buffer_load_dwordx4 v9, s[24:27], s65 offen offset:1024 nt lds
buffer_load_dwordx4 v10, s[24:27], s65 offen offset:2048 nt lds
buffer_load_dwordx4 v11, s[24:27], s65 offen offset:3072 nt lds
s_mov_b32 m0, s66
v_xor_b32 v12, 128, v8
v_xor_b32 v13, 160, v8
v_xor_b32 v14, 192, v8
v_xor_b32 v15, 224, v8
buffer_load_dwordx4 v12, s[24:27], s66 offen offset:0 nt lds
buffer_load_dwordx4 v13, s[24:27], s66 offen offset:1024 nt lds
buffer_load_dwordx4 v14, s[24:27], s66 offen offset:2048 nt lds
buffer_load_dwordx4 v15, s[24:27], s66 offen offset:3072 nt lds
s_lshr_b32 s49, s69, 4
s_and_b32 s50, s69, 15
s_lshl_b32 s15, s49, 7
s_add_u32 s15, s15, 3145728
s_load_dword s44, s[16:17], s15
v_and_b32 v0, 63, v0
v_lshrrev_b32 v3, 4, v0
v_and_b32 v4, 15, v0
s_mov_b32 s40, s16
s_mov_b32 s41, s17
s_mov_b32 s42, 3149824
s_mov_b32 s43, 0x20000
s_lshl_b32 s47, s69, 13
v_lshlrev_b32 v17, 4, v0
s_add_u32 s1, s1, 1
s_mul_i32 s1, s1, 0x01010101
s_cmp_ge_u32 s48, 4
s_cbranch_scc1 L_group_b
s_lshr_b32 s51, s69, 2
s_lshl_b32 s51, s51, 18
s_and_b32 s61, s69, 3
s_lshl_b32 s61, s61, 7
s_add_u32 s51, s51, s61
s_add_u32 s28, s8, s51
s_addc_u32 s29, s9, 0
s_mov_b32 s30, 261760
s_mov_b32 s31, 0x20000
s_sub_u32 s30, 262144, s61
s_lshl_b32 s96, s48, 10
s_add_u32 s96, s96, 65536
s_lshl_b32 s97, s48, 12
s_and_b32 s51, s48, 1
s_lshl_b32 s51, s51, 2
v_and_b32 v5, 1, v3
v_lshlrev_b32 v5, 1, v5
v_or_b32 v5, s51, v5
v_and_b32 v6, 7, v0
v_xor_b32 v5, v5, v6
v_lshlrev_b32 v5, 4, v5
v_lshrrev_b32 v6, 3, v0
v_lshl_add_u32 v16, v6, 9, v5
s_mov_b32 s52, 0x100001
s_mov_b32 s53, 0x10000100
s_mov_b32 s54, 0x200002
s_mov_b32 s55, 0x20000200
s_mov_b32 s56, 0x400004
s_mov_b32 s57, 0x40000400
s_mov_b32 s58, 0x800008
s_mov_b32 s59, 0x80000800
s_mov_b32 s62, 0
s_mov_b32 s63, -1
s_mov_b32 s64, 0xbe000000
s_mov_b32 s14, 0x80008000
v_mov_b32 v26, 1.0
s_add_u32 s20, s4, s60
s_addc_u32 s21, s5, 0
s_mov_b32 s22, 65536
s_mov_b32 s23, 0x20000
s_add_u32 s36, s12, s60
s_addc_u32 s37, s13, 0
s_mov_b32 s38, 65536
s_mov_b32 s39, 0x20000
v_xor_b32 v5, v3, v4
v_lshlrev_b32 v5, 4, v5
v_lshl_add_u32 v5, v4, 9, v5
v_add_u32 v20, s65, v5
v_xor_b32 v21, 64, v20
v_xor_b32 v22, 128, v20
v_xor_b32 v23, 192, v20
v_lshrrev_b32 v5, 3, v4
v_lshlrev_b32 v5, 9, v5
v_lshl_add_u32 v5, v3, 7, v5
v_and_b32 v6, 7, v4
v_lshl_add_u32 v5, v6, 4, v5
v_add_u32 v27, 135168, v5
v_lshlrev_b32 v5, 1, v6
v_xor_b32 v5, v5, v3
v_lshlrev_b32 v5, 4, v5
v_lshl_add_u32 v5, v6, 9, v5
v_add_u32 v148, 131072, v5
v_xor_b32 v149, 64, v148
v_xor_b32 v150, 128, v148
v_xor_b32 v151, 192, v148
v_lshlrev_b32 v5, 4, v6
v_lshl_add_u32 v158, v1, 7, v5
s_lshl_b32 s51, s48, 8
s_add_u32 s19, s47, s51
s_waitcnt lgkmcnt(0)
s_add_u32 s44, s44, 1
s_and_b32 s61, s48, 3
s_lshl_b32 s61, s61, 4
v_lshrrev_b32 v7, 4, v158
v_add_u32 v7, s61, v7
s_mov_b32 s51, 0x9e3779b1
v_mul_lo_u32 v5, v7, s51
v_add_u32 v5, s44, v5
v_lshrrev_b32 v6, 16, v5
v_xor_b32 v5, v5, v6
s_mov_b32 s51, 0x85ebca6b
v_mul_lo_u32 v5, v5, s51
v_lshrrev_b32 v6, 13, v5
v_xor_b32 v5, v5, v6
s_mov_b32 s51, 0xc2b2ae35
v_mul_lo_u32 v5, v5, s51
v_lshrrev_b32 v6, 16, v5
v_xor_b32 v132, v5, v6
v_alignbit_b32 v133, v132, v132, 3
v_alignbit_b32 v134, v132, v132, 6
v_alignbit_b32 v135, v132, v132, 9
s_mov_b32 s51, 0x9e3779b1
v_mul_lo_u32 v5, v0, s51
v_add_u32 v5, s44, v5
v_lshrrev_b32 v6, 16, v5
v_xor_b32 v5, v5, v6
s_mov_b32 s51, 0x85ebca6b
v_mul_lo_u32 v5, v5, s51
v_lshrrev_b32 v6, 13, v5
v_xor_b32 v5, v5, v6
s_mov_b32 s51, 0xc2b2ae35
v_mul_lo_u32 v5, v5, s51
v_lshrrev_b32 v6, 16, v5
v_xor_b32 v144, v5, v6
v_alignbit_b32 v145, v144, v144, 3
v_alignbit_b32 v146, v144, v144, 6
v_alignbit_b32 v147, v144, v144, 9
v_and_b32 v144, 7, v144
v_and_b32 v145, 7, v145
v_and_b32 v146, 7, v146
v_and_b32 v147, 7, v147
v_and_b32 v7, 1, v3
v_lshlrev_b32 v7, 2, v7
v_lshrrev_b32 v6, 2, v4
v_add_u32 v7, v7, v6
s_mov_b32 s51, 0x9e3779b1
v_mul_lo_u32 v5, v7, s51
v_add_u32 v5, s44, v5
v_lshrrev_b32 v6, 16, v5
v_xor_b32 v5, v5, v6
s_mov_b32 s51, 0x85ebca6b
v_mul_lo_u32 v5, v5, s51
v_lshrrev_b32 v6, 13, v5
v_xor_b32 v5, v5, v6
s_mov_b32 s51, 0xc2b2ae35
v_mul_lo_u32 v5, v5, s51
v_lshrrev_b32 v6, 16, v5
v_xor_b32 v200, v5, v6
v_alignbit_b32 v201, v200, v200, 3
v_alignbit_b32 v202, v200, v200, 6
v_alignbit_b32 v203, v200, v200, 9
v_and_b32 v200, 7, v200
v_and_b32 v201, 7, v201
v_and_b32 v202, 7, v202
v_and_b32 v203, 7, v203
s_barrier
ds_read_b128 v[32:35], v148 offset:0
ds_read_b128 v[36:39], v149 offset:0
ds_read_b128 v[40:43], v150 offset:0
ds_read_b128 v[44:47], v151 offset:0
ds_read_b128 v[48:51], v148 offset:256
ds_read_b128 v[52:55], v149 offset:256
ds_read_b128 v[56:59], v150 offset:256
ds_read_b128 v[60:63], v151 offset:256
s_lshl_b32 s51, s49, 4
buffer_load_dwordx4 v[128:131], off, s[92:95], s51 sc1
s_add_u32 m0, s96, 0
s_add_u32 s51, s97, 0
buffer_load_dwordx4 v16, s[28:31], s51 offen nt lds
s_add_u32 m0, s96, 4096
s_add_u32 s51, s97, 16384
buffer_load_dwordx4 v16, s[28:31], s51 offen nt lds
s_add_u32 m0, s96, 8192
s_add_u32 s51, s97, 32768
buffer_load_dwordx4 v16, s[28:31], s51 offen nt lds
s_add_u32 m0, s96, 12288
s_add_u32 s51, s97, 49152
buffer_load_dwordx4 v16, s[28:31], s51 offen nt lds
s_waitcnt vmcnt(5) lgkmcnt(0)
ds_read_b128 v[64:67], v20 offset:0
ds_read_b128 v[68:71], v21 offset:0
ds_read_b128 v[72:75], v22 offset:0
ds_read_b128 v[76:79], v23 offset:0
ds_read_b128 v[80:83], v20 offset:256
ds_read_b128 v[84:87], v21 offset:256
ds_read_b128 v[88:91], v22 offset:256
ds_read_b128 v[92:95], v23 offset:256
s_waitcnt lgkmcnt(7)
v_mfma_f32_16x16x32_bf16 v[100:103], v[64:67], v[64:67], 0
v_mfma_f32_16x16x32_bf16 v[96:99], v[64:67], v[32:35], 0
s_waitcnt lgkmcnt(6)
v_mfma_f32_16x16x32_bf16 v[100:103], v[68:71], v[68:71], v[100:103]
v_mfma_f32_16x16x32_bf16 v[96:99], v[68:71], v[36:39], v[96:99]
s_waitcnt lgkmcnt(5)
v_mfma_f32_16x16x32_bf16 v[100:103], v[72:75], v[72:75], v[100:103]
v_mfma_f32_16x16x32_bf16 v[96:99], v[72:75], v[40:43], v[96:99]
s_waitcnt lgkmcnt(4)
v_mfma_f32_16x16x32_bf16 v[100:103], v[76:79], v[76:79], v[100:103]
v_mfma_f32_16x16x32_bf16 v[96:99], v[76:79], v[44:47], v[96:99]
s_waitcnt lgkmcnt(3)
v_mfma_f32_16x16x32_bf16 v[100:103], v[80:83], v[80:83], v[100:103]
v_mfma_f32_16x16x32_bf16 v[96:99], v[80:83], v[48:51], v[96:99]
s_waitcnt lgkmcnt(2)
v_mfma_f32_16x16x32_bf16 v[100:103], v[84:87], v[84:87], v[100:103]
v_mfma_f32_16x16x32_bf16 v[96:99], v[84:87], v[52:55], v[96:99]
s_waitcnt lgkmcnt(1)
v_mfma_f32_16x16x32_bf16 v[100:103], v[88:91], v[88:91], v[100:103]
v_mfma_f32_16x16x32_bf16 v[96:99], v[88:91], v[56:59], v[96:99]
s_waitcnt lgkmcnt(0)
v_mfma_f32_16x16x32_bf16 v[100:103], v[92:95], v[92:95], v[100:103]
v_mfma_f32_16x16x32_bf16 v[96:99], v[92:95], v[60:63], v[96:99]
s_nop 6
v_cndmask_b32 v108, 0, v100, s[52:53]
v_cndmask_b32 v108, v108, v101, s[54:55]
v_cndmask_b32 v108, v108, v102, s[56:57]
v_cndmask_b32 v108, v108, v103, s[58:59]
v_cvt_pk_bf16_f32 v96, 0, v96
v_cvt_pk_bf16_f32 v97, 0, v97
v_mfma_f32_16x16x4_f32 v[104:107], v108, v26, 0
v_cvt_pk_bf16_f32 v98, 0, v98
v_cvt_pk_bf16_f32 v99, 0, v99
s_nop 7
v_cvt_pk_bf16_f32 v104, 0, v104
v_cvt_pk_bf16_f32 v105, 0, v105
v_cvt_pk_bf16_f32 v106, 0, v106
v_cvt_pk_bf16_f32 v107, 0, v107
v_fma_f32 v96, v104, s64, v96
v_fma_f32 v97, v105, s64, v97
v_fma_f32 v98, v106, s64, v98
v_fma_f32 v99, v107, s64, v99
v_cvt_pk_bf16_f32 v96, 0, v96
v_cvt_pk_bf16_f32 v97, 0, v97
v_cvt_pk_bf16_f32 v98, 0, v98
v_cvt_pk_bf16_f32 v99, 0, v99
v_mul_f32 v96, 0x3eb8aa3b, v96
v_mul_f32 v97, 0x3eb8aa3b, v97
v_mul_f32 v98, 0x3eb8aa3b, v98
v_mul_f32 v99, 0x3eb8aa3b, v99
v_exp_f32 v96, v96
v_exp_f32 v97, v97
v_exp_f32 v98, v98
v_exp_f32 v99, v99
v_cvt_pk_bf16_f32 v96, 0, v96
v_cvt_pk_bf16_f32 v97, 0, v97
v_cvt_pk_bf16_f32 v98, 0, v98
v_cvt_pk_bf16_f32 v99, 0, v99
v_mul_f32 v96, 0x3eb504f3, v96
v_mul_f32 v97, 0x3eb504f3, v97
v_mul_f32 v98, 0x3eb504f3, v98
v_mul_f32 v99, 0x3eb504f3, v99
v_cvt_pk_bf16_f32 v96, 0, v96
v_cvt_pk_bf16_f32 v97, 0, v97
v_cvt_pk_bf16_f32 v98, 0, v98
v_cvt_pk_bf16_f32 v99, 0, v99
v_add_f32 v96, 0x358637bd, v96
v_add_f32 v97, 0x358637bd, v97
v_add_f32 v98, 0x358637bd, v98
v_add_f32 v99, 0x358637bd, v99
v_cvt_pk_bf16_f32 v110, v96, v97
v_cvt_pk_bf16_f32 v111, v98, v99
s_add_u32 m0, s96, 16384
s_add_u32 s51, s97, 65536
buffer_load_dwordx4 v16, s[28:31], s51 offen nt lds
s_add_u32 m0, s96, 20480
s_add_u32 s51, s97, 81920
buffer_load_dwordx4 v16, s[28:31], s51 offen nt lds
s_add_u32 m0, s96, 24576
s_add_u32 s51, s97, 98304
buffer_load_dwordx4 v16, s[28:31], s51 offen nt lds
s_waitcnt vmcnt(7)
v_mov_b32 v118, v110
v_mov_b32 v119, v111
s_mov_b32 s0, 1
v_xor_b32 v128, s1, v128
v_xor_b32 v129, s1, v129
v_xor_b32 v130, s1, v130
v_xor_b32 v131, s1, v131
v_or3_b32 v5, v128, v129, v130
v_or_b32 v5, v5, v131
v_cmp_ne_u32 vcc, 0, v5
s_cbranch_vccnz L_ida
L_idda:
v_permlane16_swap_b32 v110, v118
v_permlane16_swap_b32 v111, v119
v_bfi_b32 v116, s14, v132, v110
v_bfi_b32 v117, s14, v133, v111
v_bfi_b32 v118, s14, v134, v118
v_bfi_b32 v119, s14, v135, v119
s_mov_b32 exec_lo, 0xff
s_mov_b32 exec_hi, 0xff
s_cmp_eq_u32 s0, 1
s_cbranch_scc0 L_ppa_r
buffer_store_dwordx4 v[116:119], v158, s[40:43], s19 offen
L_ppa_d:
s_mov_b64 exec, -1
s_and_b32 s61, s50, 3
s_cmp_eq_u32 s61, 3
s_cbranch_scc1 L_nopf
s_lshl_b32 s51, s61, 2
s_add_u32 s51, s51, s48
s_mul_i32 s51, s51, 6144
s_lshl_b32 s61, s61, 7
s_sub_u32 s51, s51, s61
s_add_u32 s51, s51, 188800
v_lshlrev_b32 v5, 9, v0
s_mov_b64 exec, 0xfff
buffer_load_dword v206, v5, s[28:31], s51 offen
s_mov_b64 exec, -1
L_nopf:
s_add_u32 m0, s96, 28672
s_add_u32 s51, s97, 114688
s_waitcnt vmcnt(6)
buffer_load_dwordx4 v16, s[28:31], s51 offen nt lds
s_add_u32 m0, s96, 32768
s_add_u32 s51, s97, 131072
s_waitcnt vmcnt(6)
buffer_load_dwordx4 v16, s[28:31], s51 offen nt lds
s_add_u32 m0, s96, 36864
s_add_u32 s51, s97, 147456
s_waitcnt vmcnt(6)
buffer_load_dwordx4 v16, s[28:31], s51 offen nt lds
s_add_u32 m0, s96, 40960
s_add_u32 s51, s97, 163840
s_waitcnt vmcnt(6)
buffer_load_dwordx4 v16, s[28:31], s51 offen nt lds
s_add_u32 m0, s96, 45056
s_add_u32 s51, s97, 180224
s_waitcnt vmcnt(6)
buffer_load_dwordx4 v16, s[28:31], s51 offen nt lds
s_barrier
s_add_u32 m0, s96, 49152
s_add_u32 s51, s97, 196608
s_waitcnt vmcnt(6)
buffer_load_dwordx4 v16, s[28:31], s51 offen nt lds
s_add_u32 m0, s96, 53248
s_add_u32 s51, s97, 212992
s_waitcnt vmcnt(6)
buffer_load_dwordx4 v16, s[28:31], s51 offen nt lds
s_add_u32 m0, s96, 57344
s_add_u32 s51, s97, 229376
s_waitcnt vmcnt(6)
buffer_load_dwordx4 v16, s[28:31], s51 offen nt lds
s_add_u32 m0, s96, 61440
s_add_u32 s51, s97, 245760
s_waitcnt vmcnt(6)
buffer_load_dwordx4 v16, s[28:31], s51 offen nt lds
s_mov_b32 m0, s65
s_waitcnt vmcnt(6)
buffer_load_dwordx4 v8, s[20:23], s65 offen offset:0 nt lds
s_waitcnt vmcnt(6)
buffer_load_dwordx4 v9, s[20:23], s65 offen offset:1024 nt lds
s_waitcnt vmcnt(6)
s_barrier
buffer_load_dwordx4 v10, s[20:23], s65 offen offset:2048 nt lds
s_waitcnt vmcnt(6)
buffer_load_dwordx4 v11, s[20:23], s65 offen offset:3072 nt lds
s_mov_b32 m0, s66
s_waitcnt vmcnt(6)
buffer_load_dwordx4 v12, s[20:23], s66 offen offset:0 nt lds
s_waitcnt vmcnt(6)
buffer_load_dwordx4 v13, s[20:23], s66 offen offset:1024 nt lds
s_waitcnt vmcnt(6)
buffer_load_dwordx4 v14, s[20:23], s66 offen offset:2048 nt lds
s_waitcnt vmcnt(6)
buffer_load_dwordx4 v15, s[20:23], s66 offen offset:3072 nt lds
s_waitcnt vmcnt(8)
s_barrier
v_add_u32 v150, 143360, v17
v_lshlrev_b32 v5, 11, v3
v_lshl_add_u32 v151, v4, 4, v5
v_and_b32 v5, 1, v3
v_lshlrev_b32 v5, 3, v5
v_add_u32 v159, 147584, v5
s_lshl_b32 s51, s49, 4
s_add_u32 s51, s51, s48
s_lshl_b32 s98, s51, 13
s_add_u32 s98, s98, 2048
s_add_u32 s99, s98, 32768
s_add_u32 s100, s98, 65536
s_add_u32 s101, s98, 98304
s_lshl_b32 s51, s49, 4
s_and_b32 s61, s50, 3
s_add_u32 s51, s51, s61
s_lshl_b32 s3, s51, 13
s_add_u32 s3, s3, 4096
v_and_b32 v5, 3, v0
v_lshlrev_b32 v5, 15, v5
v_lshrrev_b32 v6, 2, v4
v_lshl_add_u32 v5, v6, 4, v5
v_and_b32 v6, 1, v3
v_lshl_add_u32 v148, v6, 6, v5
s_lshr_b32 s51, s48, 1
s_lshl_b32 s51, s51, 9
s_and_b32 s61, s48, 1
s_lshl_b32 s61, s61, 7
s_add_u32 s51, s51, s61
s_add_u32 s51, s51, 143360
v_bfe_u32 v5, v0, 1, 2
v_mul_u32_u24 v5, 1056, v5
v_lshl_add_u32 v5, v6, 8, v5
v_lshl_add_u32 v5, v1, 5, v5
v_bfe_u32 v6, v0, 3, 1
v_lshl_add_u32 v5, v6, 4, v5
v_and_b32 v6, 1, v0
v_lshl_add_u32 v5, v6, 3, v5
v_add_u32 v149, s51, v5
s_waitcnt vmcnt(0)
ds_read_b128 v[64:67], v20 offset:0
ds_read_b128 v[68:71], v21 offset:0
ds_read_b128 v[72:75], v22 offset:0
ds_read_b128 v[76:79], v23 offset:0
ds_read_b128 v[80:83], v20 offset:256
ds_read_b128 v[84:87], v21 offset:256
ds_read_b128 v[88:91], v22 offset:256
ds_read_b128 v[92:95], v23 offset:256
s_waitcnt lgkmcnt(7)
v_mfma_f32_16x16x32_bf16 v[100:103], v[64:67], v[64:67], 0
v_mfma_f32_16x16x32_bf16 v[96:99], v[32:35], v[64:67], 0
s_waitcnt lgkmcnt(6)
v_mfma_f32_16x16x32_bf16 v[100:103], v[68:71], v[68:71], v[100:103]
v_mfma_f32_16x16x32_bf16 v[96:99], v[36:39], v[68:71], v[96:99]
s_waitcnt lgkmcnt(5)
v_mfma_f32_16x16x32_bf16 v[100:103], v[72:75], v[72:75], v[100:103]
v_mfma_f32_16x16x32_bf16 v[96:99], v[40:43], v[72:75], v[96:99]
s_waitcnt lgkmcnt(4)
v_mfma_f32_16x16x32_bf16 v[100:103], v[76:79], v[76:79], v[100:103]
v_mfma_f32_16x16x32_bf16 v[96:99], v[44:47], v[76:79], v[96:99]
s_waitcnt lgkmcnt(3)
v_mfma_f32_16x16x32_bf16 v[100:103], v[80:83], v[80:83], v[100:103]
v_mfma_f32_16x16x32_bf16 v[96:99], v[48:51], v[80:83], v[96:99]
s_waitcnt lgkmcnt(2)
v_mfma_f32_16x16x32_bf16 v[100:103], v[84:87], v[84:87], v[100:103]
v_mfma_f32_16x16x32_bf16 v[96:99], v[52:55], v[84:87], v[96:99]
s_waitcnt lgkmcnt(1)
v_mfma_f32_16x16x32_bf16 v[100:103], v[88:91], v[88:91], v[100:103]
v_mfma_f32_16x16x32_bf16 v[96:99], v[56:59], v[88:91], v[96:99]
s_waitcnt lgkmcnt(0)
v_mfma_f32_16x16x32_bf16 v[100:103], v[92:95], v[92:95], v[100:103]
v_mfma_f32_16x16x32_bf16 v[96:99], v[60:63], v[92:95], v[96:99]
s_nop 6
v_cndmask_b32 v108, 0, v100, s[52:53]
v_cndmask_b32 v108, v108, v101, s[54:55]
v_cndmask_b32 v108, v108, v102, s[56:57]
v_cndmask_b32 v108, v108, v103, s[58:59]
v_cvt_pk_bf16_f32 v96, 0, v96
v_cvt_pk_bf16_f32 v97, 0, v97
v_mfma_f32_16x16x4_f32 v[104:107], v26, v108, 0
v_cvt_pk_bf16_f32 v98, 0, v98
v_cvt_pk_bf16_f32 v99, 0, v99
s_nop 7
v_cvt_pk_bf16_f32 v104, 0, v104
v_fma_f32 v96, v104, s64, v96
v_fma_f32 v97, v104, s64, v97
v_fma_f32 v98, v104, s64, v98
v_fma_f32 v99, v104, s64, v99
v_cvt_pk_bf16_f32 v96, 0, v96
v_cvt_pk_bf16_f32 v97, 0, v97
v_cvt_pk_bf16_f32 v98, 0, v98
v_cvt_pk_bf16_f32 v99, 0, v99
v_mul_f32 v96, 0x3eb8aa3b, v96
v_mul_f32 v97, 0x3eb8aa3b, v97
v_mul_f32 v98, 0x3eb8aa3b, v98
v_mul_f32 v99, 0x3eb8aa3b, v99
v_exp_f32 v96, v96
v_exp_f32 v97, v97
v_exp_f32 v98, v98
v_exp_f32 v99, v99
v_cvt_pk_bf16_f32 v96, 0, v96
v_cvt_pk_bf16_f32 v97, 0, v97
v_cvt_pk_bf16_f32 v98, 0, v98
v_cvt_pk_bf16_f32 v99, 0, v99
v_mul_f32 v96, 0x3eb504f3, v96
v_mul_f32 v97, 0x3eb504f3, v97
v_mul_f32 v98, 0x3eb504f3, v98
v_mul_f32 v99, 0x3eb504f3, v99
v_cvt_pk_bf16_f32 v96, 0, v96
v_cvt_pk_bf16_f32 v97, 0, v97
v_cvt_pk_bf16_f32 v98, 0, v98
v_cvt_pk_bf16_f32 v99, 0, v99
v_add_f32 v96, 0x358637bd, v96
v_add_f32 v97, 0x358637bd, v97
v_add_f32 v98, 0x358637bd, v98
v_add_f32 v99, 0x358637bd, v99
v_cvt_pk_bf16_f32 v110, v96, v97
v_cvt_pk_bf16_f32 v111, v98, v99
v_cndmask_b32 v112, v110, 0, s[62:63]
v_cndmask_b32 v113, v111, 0, s[62:63]
v_cndmask_b32 v114, 0, v110, s[62:63]
v_cndmask_b32 v115, 0, v111, s[62:63]
buffer_load_dwordx4 v[160:163], v17, s[40:43], s98 offen offset:0 sc1
buffer_load_dwordx4 v[164:167], v17, s[40:43], s98 offen offset:1024 sc1
buffer_load_dwordx4 v[168:171], v17, s[40:43], s99 offen offset:0 sc1
buffer_load_dwordx4 v[172:175], v17, s[40:43], s99 offen offset:1024 sc1
buffer_load_dwordx4 v[176:179], v17, s[40:43], s100 offen offset:0 sc1
buffer_load_dwordx4 v[180:183], v17, s[40:43], s100 offen offset:1024 sc1
buffer_load_dwordx4 v[184:187], v17, s[40:43], s101 offen offset:0 sc1
buffer_load_dwordx4 v[188:191], v17, s[40:43], s101 offen offset:1024 sc1
buffer_load_dwordx4 v[192:195], v148, s[40:43], s3 offen sc1
s_barrier
s_waitcnt vmcnt(7)
v_xor_b32 v160, v144, v160
v_xor_b32 v161, v145, v161
v_xor_b32 v162, v146, v162
v_xor_b32 v163, v147, v163
v_xor_b32 v164, v144, v164
v_xor_b32 v165, v145, v165
v_xor_b32 v166, v146, v166
v_xor_b32 v167, v147, v167
v_or3_b32 v5, v160, v161, v162
v_or3_b32 v5, v5, v163, v164
v_or3_b32 v5, v5, v165, v166
v_or_b32 v5, v5, v167
s_waitcnt vmcnt(5)
v_xor_b32 v168, v144, v168
v_xor_b32 v169, v145, v169
v_xor_b32 v170, v146, v170
v_xor_b32 v171, v147, v171
v_xor_b32 v172, v144, v172
v_xor_b32 v173, v145, v173
v_xor_b32 v174, v146, v174
v_xor_b32 v175, v147, v175
v_or3_b32 v5, v5, v168, v169
v_or3_b32 v5, v5, v170, v171
v_or3_b32 v5, v5, v172, v173
v_or3_b32 v5, v5, v174, v175
s_waitcnt vmcnt(3)
v_xor_b32 v176, v144, v176
v_xor_b32 v177, v145, v177
v_xor_b32 v178, v146, v178
v_xor_b32 v179, v147, v179
v_xor_b32 v180, v144, v180
v_xor_b32 v181, v145, v181
v_xor_b32 v182, v146, v182
v_xor_b32 v183, v147, v183
v_or3_b32 v5, v5, v176, v177
v_or3_b32 v5, v5, v178, v179
v_or3_b32 v5, v5, v180, v181
v_or3_b32 v5, v5, v182, v183
s_waitcnt vmcnt(1)
v_xor_b32 v184, v144, v184
v_xor_b32 v185, v145, v185
v_xor_b32 v186, v146, v186
v_xor_b32 v187, v147, v187
v_xor_b32 v188, v144, v188
v_xor_b32 v189, v145, v189
v_xor_b32 v190, v146, v190
v_xor_b32 v191, v147, v191
v_or3_b32 v5, v5, v184, v185
v_or3_b32 v5, v5, v186, v187
v_or3_b32 v5, v5, v188, v189
v_or3_b32 v5, v5, v190, v191
s_waitcnt vmcnt(0)
v_xor_b32 v192, v200, v192
v_xor_b32 v193, v201, v193
v_xor_b32 v194, v202, v194
v_xor_b32 v195, v203, v195
v_or3_b32 v5, v5, v192, v193
v_or3_b32 v5, v5, v194, v195
v_and_b32 v5, 7, v5
v_cmp_ne_u32 vcc, 0, v5
s_cbranch_vccnz L_gb_retry
L_gb_done:
v_pk_add_f32 v[160:161], v[160:161], v[168:169]
v_pk_add_f32 v[162:163], v[162:163], v[170:171]
v_pk_add_f32 v[164:165], v[164:165], v[172:173]
v_pk_add_f32 v[166:167], v[166:167], v[174:175]
v_pk_add_f32 v[176:177], v[176:177], v[184:185]
v_pk_add_f32 v[178:179], v[178:179], v[186:187]
v_pk_add_f32 v[180:181], v[180:181], v[188:189]
v_pk_add_f32 v[182:183], v[182:183], v[190:191]
v_pk_add_f32 v[160:161], v[160:161], v[176:177]
v_pk_add_f32 v[162:163], v[162:163], v[178:179]
v_pk_add_f32 v[164:165], v[164:165], v[180:181]
v_pk_add_f32 v[166:167], v[166:167], v[182:183]
v_cvt_pk_bf16_f32 v160, v160, v161
v_cvt_pk_bf16_f32 v161, v162, v163
v_cvt_pk_bf16_f32 v162, v164, v165
v_cvt_pk_bf16_f32 v163, v166, v167
ds_write_b64 v149, v[160:161]
ds_write_b64 v149, v[162:163] offset:64
v_add_f32_dpp v192, v192, v192 quad_perm:[1,0,3,2] row_mask:0xf bank_mask:0xf
v_add_f32_dpp v193, v193, v193 quad_perm:[1,0,3,2] row_mask:0xf bank_mask:0xf
v_add_f32_dpp v194, v194, v194 quad_perm:[1,0,3,2] row_mask:0xf bank_mask:0xf
v_add_f32_dpp v195, v195, v195 quad_perm:[1,0,3,2] row_mask:0xf bank_mask:0xf
v_add_f32_dpp v192, v192, v192 quad_perm:[2,3,0,1] row_mask:0xf bank_mask:0xf
v_add_f32_dpp v193, v193, v193 quad_perm:[2,3,0,1] row_mask:0xf bank_mask:0xf
v_add_f32_dpp v194, v194, v194 quad_perm:[2,3,0,1] row_mask:0xf bank_mask:0xf
v_add_f32_dpp v195, v195, v195 quad_perm:[2,3,0,1] row_mask:0xf bank_mask:0xf
v_cvt_pk_bf16_f32 v192, v192, v193
v_cvt_pk_bf16_f32 v193, v194, v195
ds_write_b64 v159, v[192:193]
s_or_b32 s51, s50, s48
v_mfma_f32_16x16x16_bf16 v[152:155], v[112:113], v[192:193], 0
s_waitcnt lgkmcnt(0)
s_barrier
ds_read_b128 v[224:227], v150 offset:0
ds_read_b128 v[228:231], v150 offset:1056
ds_read_b128 v[232:235], v150 offset:2112
ds_read_b128 v[236:239], v150 offset:3168
s_cbranch_scc0 L_bump
L_bumped:
s_nop 0
L_out:
v_cvt_pk_bf16_f32 v152, 0, v152
v_cvt_pk_bf16_f32 v153, 0, v153
v_cvt_pk_bf16_f32 v154, 0, v154
v_cvt_pk_bf16_f32 v155, 0, v155
v_add_f32 v152, 0x358637bd, v152
v_add_f32 v153, 0x358637bd, v153
v_add_f32 v154, 0x358637bd, v154
v_add_f32 v155, 0x358637bd, v155
v_cvt_pk_bf16_f32 v152, 0, v152
v_cvt_pk_bf16_f32 v153, 0, v153
v_cvt_pk_bf16_f32 v154, 0, v154
v_cvt_pk_bf16_f32 v155, 0, v155
v_mul_f32 v152, 0x3e800000, v152
v_mul_f32 v153, 0x3e800000, v153
v_mul_f32 v154, 0x3e800000, v154
v_mul_f32 v155, 0x3e800000, v155
v_rcp_f32 v152, v152
v_rcp_f32 v153, v153
v_rcp_f32 v154, v154
v_rcp_f32 v155, v155
v_mul_f32 v152, 0x3e800000, v152
v_mul_f32 v153, 0x3e800000, v153
v_mul_f32 v154, 0x3e800000, v154
v_mul_f32 v155, 0x3e800000, v155
s_waitcnt lgkmcnt(3)
v_mfma_f32_16x16x16_bf16 v[32:35], v[112:113], v[224:225], 0
v_mfma_f32_16x16x16_bf16 v[36:39], v[112:113], v[226:227], 0
s_waitcnt lgkmcnt(2)
v_mfma_f32_16x16x16_bf16 v[40:43], v[112:113], v[228:229], 0
v_mfma_f32_16x16x16_bf16 v[44:47], v[112:113], v[230:231], 0
s_waitcnt lgkmcnt(1)
v_mfma_f32_16x16x16_bf16 v[48:51], v[112:113], v[232:233], 0
v_mfma_f32_16x16x16_bf16 v[52:55], v[112:113], v[234:235], 0
s_waitcnt lgkmcnt(0)
v_mfma_f32_16x16x16_bf16 v[56:59], v[112:113], v[236:237], 0
v_mfma_f32_16x16x16_bf16 v[60:63], v[112:113], v[238:239], 0
v_mfma_f32_16x16x16_bf16 v[116:119], v[114:115], v[224:225], 0
v_pk_mul_f32 v[32:33], v[32:33], v[152:153]
v_pk_mul_f32 v[36:37], v[36:37], v[152:153]
v_mfma_f32_16x16x16_bf16 v[120:123], v[114:115], v[226:227], 0
v_pk_mul_f32 v[40:41], v[40:41], v[152:153]
v_pk_mul_f32 v[44:45], v[44:45], v[152:153]
v_mfma_f32_16x16x16_bf16 v[124:127], v[114:115], v[228:229], 0
v_pk_mul_f32 v[48:49], v[48:49], v[152:153]
v_pk_mul_f32 v[52:53], v[52:53], v[152:153]
v_mfma_f32_16x16x16_bf16 v[128:131], v[114:115], v[230:231], 0
v_pk_mul_f32 v[56:57], v[56:57], v[152:153]
v_pk_mul_f32 v[60:61], v[60:61], v[152:153]
v_cvt_pk_bf16_f32 v64, v32, v36
v_cvt_pk_bf16_f32 v65, v40, v44
v_cvt_pk_bf16_f32 v66, v48, v52
v_cvt_pk_bf16_f32 v67, v56, v60
buffer_store_dwordx4 v[64:67], v151, s[36:39], s65 offen offset:0 nt
v_cvt_pk_bf16_f32 v68, v33, v37
v_cvt_pk_bf16_f32 v69, v41, v45
v_cvt_pk_bf16_f32 v70, v49, v53
v_cvt_pk_bf16_f32 v71, v57, v61
buffer_store_dwordx4 v[68:71], v151, s[36:39], s65 offen offset:512 nt
v_mfma_f32_16x16x16_bf16 v[132:135], v[114:115], v[232:233], 0
v_pk_mul_f32 v[34:35], v[34:35], v[154:155]
v_pk_mul_f32 v[38:39], v[38:39], v[154:155]
v_mfma_f32_16x16x16_bf16 v[136:139], v[114:115], v[234:235], 0
v_pk_mul_f32 v[42:43], v[42:43], v[154:155]
v_pk_mul_f32 v[46:47], v[46:47], v[154:155]
v_mfma_f32_16x16x16_bf16 v[140:143], v[114:115], v[236:237], 0
v_pk_mul_f32 v[50:51], v[50:51], v[154:155]
v_pk_mul_f32 v[54:55], v[54:55], v[154:155]
v_mfma_f32_16x16x16_bf16 v[144:147], v[114:115], v[238:239], 0
v_pk_mul_f32 v[58:59], v[58:59], v[154:155]
v_pk_mul_f32 v[62:63], v[62:63], v[154:155]
v_cvt_pk_bf16_f32 v72, v34, v38
v_cvt_pk_bf16_f32 v73, v42, v46
v_cvt_pk_bf16_f32 v74, v50, v54
v_cvt_pk_bf16_f32 v75, v58, v62
buffer_store_dwordx4 v[72:75], v151, s[36:39], s65 offen offset:1024 nt
v_cvt_pk_bf16_f32 v76, v35, v39
v_cvt_pk_bf16_f32 v77, v43, v47
v_cvt_pk_bf16_f32 v78, v51, v55
v_cvt_pk_bf16_f32 v79, v59, v63
buffer_store_dwordx4 v[76:79], v151, s[36:39], s65 offen offset:1536 nt
v_pk_mul_f32 v[116:117], v[116:117], v[152:153]
v_pk_mul_f32 v[120:121], v[120:121], v[152:153]
v_pk_mul_f32 v[124:125], v[124:125], v[152:153]
v_pk_mul_f32 v[128:129], v[128:129], v[152:153]
v_pk_mul_f32 v[132:133], v[132:133], v[152:153]
v_pk_mul_f32 v[136:137], v[136:137], v[152:153]
v_pk_mul_f32 v[140:141], v[140:141], v[152:153]
v_pk_mul_f32 v[144:145], v[144:145], v[152:153]
v_cvt_pk_bf16_f32 v80, v116, v120
v_cvt_pk_bf16_f32 v81, v124, v128
v_cvt_pk_bf16_f32 v82, v132, v136
v_cvt_pk_bf16_f32 v83, v140, v144
buffer_store_dwordx4 v[80:83], v151, s[36:39], s65 offen offset:256 nt
v_cvt_pk_bf16_f32 v84, v117, v121
v_cvt_pk_bf16_f32 v85, v125, v129
v_cvt_pk_bf16_f32 v86, v133, v137
v_cvt_pk_bf16_f32 v87, v141, v145
buffer_store_dwordx4 v[84:87], v151, s[36:39], s65 offen offset:768 nt
v_pk_mul_f32 v[118:119], v[118:119], v[154:155]
v_pk_mul_f32 v[122:123], v[122:123], v[154:155]
v_pk_mul_f32 v[126:127], v[126:127], v[154:155]
v_pk_mul_f32 v[130:131], v[130:131], v[154:155]
v_pk_mul_f32 v[134:135], v[134:135], v[154:155]
v_pk_mul_f32 v[138:139], v[138:139], v[154:155]
v_pk_mul_f32 v[142:143], v[142:143], v[154:155]
v_pk_mul_f32 v[146:147], v[146:147], v[154:155]
v_cvt_pk_bf16_f32 v88, v118, v122
v_cvt_pk_bf16_f32 v89, v126, v130
v_cvt_pk_bf16_f32 v90, v134, v138
v_cvt_pk_bf16_f32 v91, v142, v146
buffer_store_dwordx4 v[88:91], v151, s[36:39], s65 offen offset:1280 nt
v_cvt_pk_bf16_f32 v92, v119, v123
v_cvt_pk_bf16_f32 v93, v127, v131
v_cvt_pk_bf16_f32 v94, v135, v139
v_cvt_pk_bf16_f32 v95, v143, v147
buffer_store_dwordx4 v[92:95], v151, s[36:39], s65 offen offset:1792 nt
L_end:
s_endpgm
L_group_b:
s_setprio 1
s_waitcnt vmcnt(8) lgkmcnt(0)
s_barrier
s_lshl_b32 s51, s49, 4
buffer_load_dwordx4 v[128:131], off, s[92:95], s51 sc1
s_mov_b32 s52, 0x100001
s_mov_b32 s53, 0x10000100
s_mov_b32 s54, 0x200002
s_mov_b32 s55, 0x20000200
s_mov_b32 s56, 0x400004
s_mov_b32 s57, 0x40000400
s_mov_b32 s58, 0x800008
s_mov_b32 s59, 0x80000800
s_mov_b32 s62, 0
s_mov_b32 s63, -1
s_mov_b32 s64, 0xbe000000
s_mov_b32 s14, 0x80008000
v_mov_b32 v26, 1.0
s_add_u32 s20, s4, s60
s_addc_u32 s21, s5, 0
s_mov_b32 s22, 65536
s_mov_b32 s23, 0x20000
s_add_u32 s36, s12, s60
s_addc_u32 s37, s13, 0
s_mov_b32 s38, 65536
s_mov_b32 s39, 0x20000
v_xor_b32 v5, v3, v4
v_lshlrev_b32 v5, 4, v5
v_lshl_add_u32 v5, v4, 9, v5
v_add_u32 v20, s65, v5
v_xor_b32 v21, 64, v20
v_xor_b32 v22, 128, v20
v_xor_b32 v23, 192, v20
v_lshrrev_b32 v5, 3, v4
v_lshlrev_b32 v5, 9, v5
v_lshl_add_u32 v5, v3, 7, v5
v_and_b32 v6, 7, v4
v_lshl_add_u32 v5, v6, 4, v5
v_add_u32 v27, 135168, v5
v_lshlrev_b32 v5, 1, v6
v_xor_b32 v5, v5, v3
v_lshlrev_b32 v5, 4, v5
v_lshl_add_u32 v5, v6, 9, v5
v_add_u32 v148, 131072, v5
v_xor_b32 v149, 64, v148
v_xor_b32 v150, 128, v148
v_xor_b32 v151, 192, v148
v_lshlrev_b32 v5, 4, v6
v_lshl_add_u32 v158, v1, 7, v5
s_lshl_b32 s51, s48, 8
s_add_u32 s19, s47, s51
ds_read_b128 v[32:35], v148 offset:0
ds_read_b128 v[36:39], v149 offset:0
ds_read_b128 v[40:43], v150 offset:0
ds_read_b128 v[44:47], v151 offset:0
ds_read_b128 v[48:51], v148 offset:256
ds_read_b128 v[52:55], v149 offset:256
ds_read_b128 v[56:59], v150 offset:256
ds_read_b128 v[60:63], v151 offset:256
s_and_b32 s51, s48, 3
v_bfe_u32 v5, v0, 3, 2
v_xor_b32 v5, s51, v5
v_lshlrev_b32 v5, 5, v5
v_lshl_add_u32 v5, v3, 10, v5
v_bfe_u32 v6, v0, 2, 2
v_lshl_add_u32 v5, v6, 7, v5
v_and_b32 v6, 3, v0
v_lshl_add_u32 v5, v6, 3, v5
v_add_u32 v24, 65536, v5
s_and_b32 s61, s69, 0xfc
s_add_u32 s61, s61, s51
s_lshl_b32 s96, s61, 13
s_lshl_b32 s61, s51, 11
s_add_u32 s61, s61, 135168
v_add_u32 v25, s61, v17
s_lshl_b32 s51, s51, 9
s_add_u32 s97, s47, s51
s_add_u32 s97, s97, 2048
s_add_u32 s44, s44, 1
s_and_b32 s61, s48, 3
s_lshl_b32 s61, s61, 4
v_lshrrev_b32 v7, 4, v158
v_add_u32 v7, s61, v7
s_mov_b32 s51, 0x9e3779b1
v_mul_lo_u32 v5, v7, s51
v_add_u32 v5, s44, v5
v_lshrrev_b32 v6, 16, v5
v_xor_b32 v5, v5, v6
s_mov_b32 s51, 0x85ebca6b
v_mul_lo_u32 v5, v5, s51
v_lshrrev_b32 v6, 13, v5
v_xor_b32 v5, v5, v6
s_mov_b32 s51, 0xc2b2ae35
v_mul_lo_u32 v5, v5, s51
v_lshrrev_b32 v6, 16, v5
v_xor_b32 v132, v5, v6
v_alignbit_b32 v133, v132, v132, 3
v_alignbit_b32 v134, v132, v132, 6
v_alignbit_b32 v135, v132, v132, 9
s_and_b32 s61, s48, 1
s_lshl_b32 s61, s61, 5
v_add_u32 v7, s61, v2
s_mov_b32 s51, 0x9e3779b1
v_mul_lo_u32 v5, v7, s51
v_add_u32 v5, s44, v5
v_lshrrev_b32 v6, 16, v5
v_xor_b32 v5, v5, v6
s_mov_b32 s51, 0x85ebca6b
v_mul_lo_u32 v5, v5, s51
v_lshrrev_b32 v6, 13, v5
v_xor_b32 v5, v5, v6
s_mov_b32 s51, 0xc2b2ae35
v_mul_lo_u32 v5, v5, s51
v_lshrrev_b32 v6, 16, v5
v_xor_b32 v136, v5, v6
v_alignbit_b32 v137, v136, v136, 3
v_alignbit_b32 v138, v136, v136, 6
v_alignbit_b32 v139, v136, v136, 9
s_mov_b32 s51, 0x9e3779b1
v_mul_lo_u32 v5, v0, s51
v_add_u32 v5, s44, v5
v_lshrrev_b32 v6, 16, v5
v_xor_b32 v5, v5, v6
s_mov_b32 s51, 0x85ebca6b
v_mul_lo_u32 v5, v5, s51
v_lshrrev_b32 v6, 13, v5
v_xor_b32 v5, v5, v6
s_mov_b32 s51, 0xc2b2ae35
v_mul_lo_u32 v5, v5, s51
v_lshrrev_b32 v6, 16, v5
v_xor_b32 v140, v5, v6
v_alignbit_b32 v141, v140, v140, 3
v_alignbit_b32 v142, v140, v140, 6
v_alignbit_b32 v143, v140, v140, 9
v_and_b32 v140, s14, v140
v_and_b32 v141, s14, v141
v_and_b32 v142, s14, v142
v_and_b32 v143, s14, v143
v_lshl_add_u32 v7, v3, 2, v4
s_mov_b32 s51, 0x9e3779b1
v_mul_lo_u32 v5, v7, s51
v_add_u32 v5, s44, v5
v_lshrrev_b32 v6, 16, v5
v_xor_b32 v5, v5, v6
s_mov_b32 s51, 0x85ebca6b
v_mul_lo_u32 v5, v5, s51
v_lshrrev_b32 v6, 13, v5
v_xor_b32 v5, v5, v6
s_mov_b32 s51, 0xc2b2ae35
v_mul_lo_u32 v5, v5, s51
v_lshrrev_b32 v6, 16, v5
v_xor_b32 v144, v5, v6
v_alignbit_b32 v145, v144, v144, 3
v_alignbit_b32 v146, v144, v144, 6
v_alignbit_b32 v147, v144, v144, 9
s_waitcnt vmcnt(1) lgkmcnt(0)
ds_read_b128 v[64:67], v20 offset:0
ds_read_b128 v[68:71], v21 offset:0
ds_read_b128 v[72:75], v22 offset:0
ds_read_b128 v[76:79], v23 offset:0
ds_read_b128 v[80:83], v20 offset:256
ds_read_b128 v[84:87], v21 offset:256
ds_read_b128 v[88:91], v22 offset:256
ds_read_b128 v[92:95], v23 offset:256
v_add_u32 v150, 143360, v17
v_lshlrev_b32 v5, 11, v3
v_lshl_add_u32 v151, v4, 4, v5
v_and_b32 v5, 1, v3
v_lshlrev_b32 v5, 3, v5
v_add_u32 v159, 147584, v5
v_mov_b32 v28, 0x3f803f80
v_mov_b32 v29, 0x3f803f80
v_mov_b32 v30, 0x3f803f80
v_mov_b32 v31, 0x3f803f80
v_lshlrev_b32 v5, 6, v3
v_lshl_add_u32 v148, v4, 4, v5
s_waitcnt lgkmcnt(7)
v_mfma_f32_16x16x32_bf16 v[100:103], v[64:67], v[64:67], 0
v_mfma_f32_16x16x32_bf16 v[96:99], v[64:67], v[32:35], 0
s_waitcnt lgkmcnt(6)
v_mfma_f32_16x16x32_bf16 v[100:103], v[68:71], v[68:71], v[100:103]
v_mfma_f32_16x16x32_bf16 v[96:99], v[68:71], v[36:39], v[96:99]
s_waitcnt lgkmcnt(5)
v_mfma_f32_16x16x32_bf16 v[100:103], v[72:75], v[72:75], v[100:103]
v_mfma_f32_16x16x32_bf16 v[96:99], v[72:75], v[40:43], v[96:99]
s_waitcnt lgkmcnt(4)
v_mfma_f32_16x16x32_bf16 v[100:103], v[76:79], v[76:79], v[100:103]
v_mfma_f32_16x16x32_bf16 v[96:99], v[76:79], v[44:47], v[96:99]
s_waitcnt lgkmcnt(3)
v_mfma_f32_16x16x32_bf16 v[100:103], v[80:83], v[80:83], v[100:103]
v_mfma_f32_16x16x32_bf16 v[96:99], v[80:83], v[48:51], v[96:99]
s_waitcnt lgkmcnt(2)
v_mfma_f32_16x16x32_bf16 v[100:103], v[84:87], v[84:87], v[100:103]
v_mfma_f32_16x16x32_bf16 v[96:99], v[84:87], v[52:55], v[96:99]
s_waitcnt lgkmcnt(1)
v_mfma_f32_16x16x32_bf16 v[100:103], v[88:91], v[88:91], v[100:103]
v_mfma_f32_16x16x32_bf16 v[96:99], v[88:91], v[56:59], v[96:99]
s_waitcnt lgkmcnt(0)
v_mfma_f32_16x16x32_bf16 v[100:103], v[92:95], v[92:95], v[100:103]
v_mfma_f32_16x16x32_bf16 v[96:99], v[92:95], v[60:63], v[96:99]
s_nop 6
v_cndmask_b32 v108, 0, v100, s[52:53]
v_cndmask_b32 v108, v108, v101, s[54:55]
v_cndmask_b32 v108, v108, v102, s[56:57]
v_cndmask_b32 v108, v108, v103, s[58:59]
v_cvt_pk_bf16_f32 v96, 0, v96
v_cvt_pk_bf16_f32 v97, 0, v97
v_mfma_f32_16x16x4_f32 v[104:107], v108, v26, 0
v_cvt_pk_bf16_f32 v98, 0, v98
v_cvt_pk_bf16_f32 v99, 0, v99
s_nop 7
v_cvt_pk_bf16_f32 v104, 0, v104
v_cvt_pk_bf16_f32 v105, 0, v105
v_cvt_pk_bf16_f32 v106, 0, v106
v_cvt_pk_bf16_f32 v107, 0, v107
v_fma_f32 v96, v104, s64, v96
v_fma_f32 v97, v105, s64, v97
v_fma_f32 v98, v106, s64, v98
v_fma_f32 v99, v107, s64, v99
v_cvt_pk_bf16_f32 v96, 0, v96
v_cvt_pk_bf16_f32 v97, 0, v97
v_cvt_pk_bf16_f32 v98, 0, v98
v_cvt_pk_bf16_f32 v99, 0, v99
v_mul_f32 v96, 0x3eb8aa3b, v96
v_mul_f32 v97, 0x3eb8aa3b, v97
v_mul_f32 v98, 0x3eb8aa3b, v98
v_mul_f32 v99, 0x3eb8aa3b, v99
v_exp_f32 v96, v96
v_exp_f32 v97, v97
v_exp_f32 v98, v98
v_exp_f32 v99, v99
v_cvt_pk_bf16_f32 v96, 0, v96
v_cvt_pk_bf16_f32 v97, 0, v97
v_cvt_pk_bf16_f32 v98, 0, v98
v_cvt_pk_bf16_f32 v99, 0, v99
v_mul_f32 v96, 0x3eb504f3, v96
v_mul_f32 v97, 0x3eb504f3, v97
v_mul_f32 v98, 0x3eb504f3, v98
v_mul_f32 v99, 0x3eb504f3, v99
v_cvt_pk_bf16_f32 v96, 0, v96
v_cvt_pk_bf16_f32 v97, 0, v97
v_cvt_pk_bf16_f32 v98, 0, v98
v_cvt_pk_bf16_f32 v99, 0, v99
v_add_f32 v96, 0x358637bd, v96
v_add_f32 v97, 0x358637bd, v97
v_add_f32 v98, 0x358637bd, v98
v_add_f32 v99, 0x358637bd, v99
v_cvt_pk_bf16_f32 v110, v96, v97
v_cvt_pk_bf16_f32 v111, v98, v99
s_waitcnt vmcnt(0)
v_mov_b32 v118, v110
v_mov_b32 v119, v111
s_mov_b32 s0, 1
v_xor_b32 v128, s1, v128
v_xor_b32 v129, s1, v129
v_xor_b32 v130, s1, v130
v_xor_b32 v131, s1, v131
v_or3_b32 v5, v128, v129, v130
v_or_b32 v5, v5, v131
v_cmp_ne_u32 vcc, 0, v5
s_cbranch_vccnz L_idb
L_iddb:
v_permlane16_swap_b32 v110, v118
v_permlane16_swap_b32 v111, v119
v_bfi_b32 v116, s14, v132, v110
v_bfi_b32 v117, s14, v133, v111
v_bfi_b32 v118, s14, v134, v118
v_bfi_b32 v119, s14, v135, v119
s_mov_b32 exec_lo, 0xff
s_mov_b32 exec_hi, 0xff
s_cmp_eq_u32 s0, 1
s_cbranch_scc0 L_ppb_r
buffer_store_dwordx4 v[116:119], v158, s[40:43], s19 offen
L_ppb_d:
s_mov_b64 exec, -1
s_barrier
s_mov_b32 s67, 0
L_ga:
buffer_load_dwordx4 v[64:67], v17, s[40:43], s96 offen offset:0 sc1
buffer_load_dwordx4 v[68:71], v17, s[40:43], s96 offen offset:1024 sc1
s_add_u32 s67, s67, 1
s_cmp_ge_u32 s67, 1000000
s_waitcnt vmcnt(0)
v_xor_b32 v64, v140, v64
v_xor_b32 v65, v141, v65
v_xor_b32 v66, v142, v66
v_xor_b32 v67, v143, v67
v_xor_b32 v68, v140, v68
v_xor_b32 v69, v141, v69
v_xor_b32 v70, v142, v70
v_xor_b32 v71, v143, v71
v_or3_b32 v5, v64, v65, v66
v_or3_b32 v5, v5, v67, v68
v_or3_b32 v5, v5, v69, v70
v_or_b32 v5, v5, v71
v_and_b32 v5, s14, v5
v_cmp_ne_u32 vcc, 0, v5
s_cbranch_scc1 L_ga_done
s_cbranch_vccnz L_ga
L_ga_done:
ds_write_b128 v25, v[64:67]
ds_write_b128 v25, v[68:71] offset:1024
s_waitcnt lgkmcnt(0)
s_barrier
ds_read_b128 v[224:227], v27 offset:0
ds_read_b64_tr_b16 v[160:161], v24 offset:0
ds_read_b64_tr_b16 v[162:163], v24 offset:512
ds_read_b64_tr_b16 v[164:165], v24 offset:4096
ds_read_b64_tr_b16 v[166:167], v24 offset:4608
ds_read_b128 v[228:231], v27 offset:1024
ds_read_b64_tr_b16 v[168:169], v24 offset:8192
ds_read_b64_tr_b16 v[170:171], v24 offset:8704
ds_read_b64_tr_b16 v[172:173], v24 offset:12288
ds_read_b64_tr_b16 v[174:175], v24 offset:12800
ds_read_b128 v[232:235], v27 offset:2048
ds_read_b64_tr_b16 v[176:177], v24 offset:16384
ds_read_b64_tr_b16 v[178:179], v24 offset:16896
ds_read_b64_tr_b16 v[180:181], v24 offset:20480
ds_read_b64_tr_b16 v[182:183], v24 offset:20992
s_waitcnt lgkmcnt(12)
v_mfma_f32_16x16x32_bf16 v[116:119], v[224:227], v[28:31], 0
v_mfma_f32_16x16x32_bf16 v[120:123], v[224:227], v[160:163], 0
s_waitcnt lgkmcnt(10)
v_mfma_f32_16x16x32_bf16 v[124:127], v[224:227], v[164:167], 0
ds_read_b128 v[236:239], v27 offset:3072
ds_read_b64_tr_b16 v[184:185], v24 offset:24576
ds_read_b64_tr_b16 v[186:187], v24 offset:25088
ds_read_b64_tr_b16 v[188:189], v24 offset:28672
ds_read_b64_tr_b16 v[190:191], v24 offset:29184
s_waitcnt lgkmcnt(12)
v_mfma_f32_16x16x32_bf16 v[116:119], v[228:231], v[28:31], v[116:119]
v_mfma_f32_16x16x32_bf16 v[120:123], v[228:231], v[168:171], v[120:123]
s_waitcnt lgkmcnt(10)
v_mfma_f32_16x16x32_bf16 v[124:127], v[228:231], v[172:175], v[124:127]
ds_read_b128 v[240:243], v27 offset:4096
ds_read_b64_tr_b16 v[192:193], v24 offset:32768
ds_read_b64_tr_b16 v[194:195], v24 offset:33280
ds_read_b64_tr_b16 v[196:197], v24 offset:36864
ds_read_b64_tr_b16 v[198:199], v24 offset:37376
s_waitcnt lgkmcnt(12)
v_mfma_f32_16x16x32_bf16 v[116:119], v[232:235], v[28:31], v[116:119]
v_mfma_f32_16x16x32_bf16 v[120:123], v[232:235], v[176:179], v[120:123]
s_waitcnt lgkmcnt(10)
v_mfma_f32_16x16x32_bf16 v[124:127], v[232:235], v[180:183], v[124:127]
ds_read_b128 v[244:247], v27 offset:5120
ds_read_b64_tr_b16 v[200:201], v24 offset:40960
ds_read_b64_tr_b16 v[202:203], v24 offset:41472
ds_read_b64_tr_b16 v[204:205], v24 offset:45056
ds_read_b64_tr_b16 v[206:207], v24 offset:45568
s_waitcnt lgkmcnt(12)
v_mfma_f32_16x16x32_bf16 v[116:119], v[236:239], v[28:31], v[116:119]
v_mfma_f32_16x16x32_bf16 v[120:123], v[236:239], v[184:187], v[120:123]
s_waitcnt lgkmcnt(10)
v_mfma_f32_16x16x32_bf16 v[124:127], v[236:239], v[188:191], v[124:127]
s_waitcnt lgkmcnt(7)
v_mfma_f32_16x16x32_bf16 v[116:119], v[240:243], v[28:31], v[116:119]
v_mfma_f32_16x16x32_bf16 v[120:123], v[240:243], v[192:195], v[120:123]
s_waitcnt lgkmcnt(5)
v_mfma_f32_16x16x32_bf16 v[124:127], v[240:243], v[196:199], v[124:127]
s_waitcnt lgkmcnt(2)
v_mfma_f32_16x16x32_bf16 v[116:119], v[244:247], v[28:31], v[116:119]
v_mfma_f32_16x16x32_bf16 v[120:123], v[244:247], v[200:203], v[120:123]
s_waitcnt lgkmcnt(0)
v_mfma_f32_16x16x32_bf16 v[124:127], v[244:247], v[204:207], v[124:127]
ds_read_b128 v[248:251], v27 offset:6144
ds_read_b128 v[252:255], v27 offset:7168
s_waitcnt lgkmcnt(0)
v_mfma_f32_16x16x32_bf16 v[116:119], v[248:251], v[28:31], v[116:119]
v_mfma_f32_16x16x32_bf16 v[116:119], v[252:255], v[28:31], v[116:119]
s_barrier
ds_read_b64_tr_b16 v[208:209], v24 offset:49152
ds_read_b64_tr_b16 v[210:211], v24 offset:49664
ds_read_b64_tr_b16 v[212:213], v24 offset:53248
ds_read_b64_tr_b16 v[214:215], v24 offset:53760
ds_read_b64_tr_b16 v[216:217], v24 offset:57344
ds_read_b64_tr_b16 v[218:219], v24 offset:57856
ds_read_b64_tr_b16 v[220:221], v24 offset:61440
ds_read_b64_tr_b16 v[222:223], v24 offset:61952
s_waitcnt lgkmcnt(6)
v_mfma_f32_16x16x32_bf16 v[120:123], v[248:251], v[208:211], v[120:123]
s_waitcnt lgkmcnt(4)
v_mfma_f32_16x16x32_bf16 v[124:127], v[248:251], v[212:215], v[124:127]
s_waitcnt lgkmcnt(2)
v_mfma_f32_16x16x32_bf16 v[120:123], v[252:255], v[216:219], v[120:123]
s_waitcnt lgkmcnt(0)
v_mfma_f32_16x16x32_bf16 v[124:127], v[252:255], v[220:223], v[124:127]
s_nop 7
v_permlane32_swap_b32 v124, v128
v_permlane32_swap_b32 v125, v129
v_permlane32_swap_b32 v126, v130
v_permlane32_swap_b32 v127, v131
v_pk_add_f32 v[120:121], v[120:121], v[128:129]
v_pk_add_f32 v[122:123], v[122:123], v[130:131]
v_bfi_b32 v120, 7, v136, v120
v_bfi_b32 v121, 7, v137, v121
v_bfi_b32 v122, 7, v138, v122
v_bfi_b32 v123, 7, v139, v123
s_mov_b32 exec_hi, 0
s_cmp_eq_u32 s0, 1
s_cbranch_scc0 L_kp_r
buffer_store_dwordx4 v[120:123], v17, s[40:43], s97 offen
L_kp_d:
s_mov_b32 exec_hi, -1
s_cmp_lg_u32 s48, 7
s_cbranch_scc1 L_noz
v_permlane32_swap_b32 v116, v128
v_permlane32_swap_b32 v117, v129
v_permlane32_swap_b32 v118, v130
v_permlane32_swap_b32 v119, v131
v_pk_add_f32 v[116:117], v[116:117], v[128:129]
v_pk_add_f32 v[118:119], v[118:119], v[130:131]
v_bfi_b32 v116, 7, v144, v116
v_bfi_b32 v117, 7, v145, v117
v_bfi_b32 v118, 7, v146, v118
v_bfi_b32 v119, 7, v147, v119
s_add_u32 s51, s47, 4096
s_mov_b64 exec, 0xf000f
s_cmp_eq_u32 s0, 1
s_cbranch_scc0 L_zp_r
buffer_store_dwordx4 v[116:119], v148, s[40:43], s51 offen
L_zp_d:
s_mov_b64 exec, -1
L_noz:
s_setprio 0
s_mov_b32 m0, s65
s_nop 0
buffer_load_dwordx4 v8, s[20:23], s65 offen offset:0 nt lds
buffer_load_dwordx4 v9, s[20:23], s65 offen offset:1024 nt lds
s_and_b32 s51, s50, 3
s_cmp_eq_u32 s51, 3
s_cbranch_scc1 L_q3
s_barrier
s_mov_b32 m0, s65
s_nop 0
buffer_load_dwordx4 v10, s[20:23], s65 offen offset:2048 nt lds
buffer_load_dwordx4 v11, s[20:23], s65 offen offset:3072 nt lds
s_mov_b32 m0, s66
s_nop 0
buffer_load_dwordx4 v12, s[20:23], s66 offen offset:0 nt lds
buffer_load_dwordx4 v13, s[20:23], s66 offen offset:1024 nt lds
buffer_load_dwordx4 v14, s[20:23], s66 offen offset:2048 nt lds
buffer_load_dwordx4 v15, s[20:23], s66 offen offset:3072 nt lds
s_branch L_q3d
L_q3:
s_mov_b32 m0, s65
s_nop 0
buffer_load_dwordx4 v10, s[20:23], s65 offen offset:2048 nt lds
buffer_load_dwordx4 v11, s[20:23], s65 offen offset:3072 nt lds
s_mov_b32 m0, s66
s_nop 0
buffer_load_dwordx4 v12, s[20:23], s66 offen offset:0 nt lds
buffer_load_dwordx4 v13, s[20:23], s66 offen offset:1024 nt lds
buffer_load_dwordx4 v14, s[20:23], s66 offen offset:2048 nt lds
buffer_load_dwordx4 v15, s[20:23], s66 offen offset:3072 nt lds
s_barrier
L_q3d:
s_barrier
ds_read_b64 v[156:157], v159
ds_read_b128 v[224:227], v150 offset:0
ds_read_b128 v[228:231], v150 offset:1056
ds_read_b128 v[232:235], v150 offset:2112
ds_read_b128 v[236:239], v150 offset:3168
s_waitcnt vmcnt(0)
ds_read_b128 v[64:67], v20 offset:0
ds_read_b128 v[68:71], v21 offset:0
ds_read_b128 v[72:75], v22 offset:0
ds_read_b128 v[76:79], v23 offset:0
ds_read_b128 v[80:83], v20 offset:256
ds_read_b128 v[84:87], v21 offset:256
ds_read_b128 v[88:91], v22 offset:256
ds_read_b128 v[92:95], v23 offset:256
s_waitcnt lgkmcnt(7)
v_mfma_f32_16x16x32_bf16 v[100:103], v[64:67], v[64:67], 0
v_mfma_f32_16x16x32_bf16 v[96:99], v[32:35], v[64:67], 0
s_waitcnt lgkmcnt(6)
v_mfma_f32_16x16x32_bf16 v[100:103], v[68:71], v[68:71], v[100:103]
v_mfma_f32_16x16x32_bf16 v[96:99], v[36:39], v[68:71], v[96:99]
s_waitcnt lgkmcnt(5)
v_mfma_f32_16x16x32_bf16 v[100:103], v[72:75], v[72:75], v[100:103]
v_mfma_f32_16x16x32_bf16 v[96:99], v[40:43], v[72:75], v[96:99]
s_waitcnt lgkmcnt(4)
v_mfma_f32_16x16x32_bf16 v[100:103], v[76:79], v[76:79], v[100:103]
v_mfma_f32_16x16x32_bf16 v[96:99], v[44:47], v[76:79], v[96:99]
s_waitcnt lgkmcnt(3)
v_mfma_f32_16x16x32_bf16 v[100:103], v[80:83], v[80:83], v[100:103]
v_mfma_f32_16x16x32_bf16 v[96:99], v[48:51], v[80:83], v[96:99]
s_waitcnt lgkmcnt(2)
v_mfma_f32_16x16x32_bf16 v[100:103], v[84:87], v[84:87], v[100:103]
v_mfma_f32_16x16x32_bf16 v[96:99], v[52:55], v[84:87], v[96:99]
s_waitcnt lgkmcnt(1)
v_mfma_f32_16x16x32_bf16 v[100:103], v[88:91], v[88:91], v[100:103]
v_mfma_f32_16x16x32_bf16 v[96:99], v[56:59], v[88:91], v[96:99]
s_waitcnt lgkmcnt(0)
v_mfma_f32_16x16x32_bf16 v[100:103], v[92:95], v[92:95], v[100:103]
v_mfma_f32_16x16x32_bf16 v[96:99], v[60:63], v[92:95], v[96:99]
s_nop 6
v_cndmask_b32 v108, 0, v100, s[52:53]
v_cndmask_b32 v108, v108, v101, s[54:55]
v_cndmask_b32 v108, v108, v102, s[56:57]
v_cndmask_b32 v108, v108, v103, s[58:59]
v_cvt_pk_bf16_f32 v96, 0, v96
v_cvt_pk_bf16_f32 v97, 0, v97
v_mfma_f32_16x16x4_f32 v[104:107], v26, v108, 0
v_cvt_pk_bf16_f32 v98, 0, v98
v_cvt_pk_bf16_f32 v99, 0, v99
s_nop 7
v_cvt_pk_bf16_f32 v104, 0, v104
v_fma_f32 v96, v104, s64, v96
v_fma_f32 v97, v104, s64, v97
v_fma_f32 v98, v104, s64, v98
v_fma_f32 v99, v104, s64, v99
v_cvt_pk_bf16_f32 v96, 0, v96
v_cvt_pk_bf16_f32 v97, 0, v97
v_cvt_pk_bf16_f32 v98, 0, v98
v_cvt_pk_bf16_f32 v99, 0, v99
v_mul_f32 v96, 0x3eb8aa3b, v96
v_mul_f32 v97, 0x3eb8aa3b, v97
v_mul_f32 v98, 0x3eb8aa3b, v98
v_mul_f32 v99, 0x3eb8aa3b, v99
v_exp_f32 v96, v96
v_exp_f32 v97, v97
v_exp_f32 v98, v98
v_exp_f32 v99, v99
v_cvt_pk_bf16_f32 v96, 0, v96
v_cvt_pk_bf16_f32 v97, 0, v97
v_cvt_pk_bf16_f32 v98, 0, v98
v_cvt_pk_bf16_f32 v99, 0, v99
v_mul_f32 v96, 0x3eb504f3, v96
v_mul_f32 v97, 0x3eb504f3, v97
v_mul_f32 v98, 0x3eb504f3, v98
v_mul_f32 v99, 0x3eb504f3, v99
v_cvt_pk_bf16_f32 v96, 0, v96
v_cvt_pk_bf16_f32 v97, 0, v97
v_cvt_pk_bf16_f32 v98, 0, v98
v_cvt_pk_bf16_f32 v99, 0, v99
v_add_f32 v96, 0x358637bd, v96
v_add_f32 v97, 0x358637bd, v97
v_add_f32 v98, 0x358637bd, v98
v_add_f32 v99, 0x358637bd, v99
v_cvt_pk_bf16_f32 v110, v96, v97
v_cvt_pk_bf16_f32 v111, v98, v99
v_cndmask_b32 v112, v110, 0, s[62:63]
v_cndmask_b32 v113, v111, 0, s[62:63]
v_cndmask_b32 v114, 0, v110, s[62:63]
v_cndmask_b32 v115, 0, v111, s[62:63]
v_mfma_f32_16x16x16_bf16 v[152:155], v[112:113], v[156:157], 0
s_nop 6
s_branch L_out
L_ida:
s_mov_b32 s61, 3
L_idra:
s_lshl_b32 s51, s49, 4
buffer_load_dwordx4 v[128:131], off, s[92:95], s51 sc1
s_waitcnt vmcnt(0)
v_xor_b32 v128, s1, v128
v_xor_b32 v129, s1, v129
v_xor_b32 v130, s1, v130
v_xor_b32 v131, s1, v131
v_or3_b32 v5, v128, v129, v130
v_or_b32 v5, v5, v131
v_cmp_ne_u32 vcc, 0, v5
s_cbranch_vccz L_idda
s_sub_u32 s61, s61, 1
s_cmp_lg_u32 s61, 0
s_cbranch_scc1 L_idra
s_mov_b32 s0, 0
s_branch L_idda
L_ppa_r:
buffer_store_dwordx4 v[116:119], v158, s[40:43], s19 offen sc1
s_branch L_ppa_d
L_gb_retry:
s_mov_b32 s68, 1
L_gb_loop:
s_mov_b32 s46, 0
v_or3_b32 v5, v160, v161, v162
v_or3_b32 v5, v5, v163, v164
v_or3_b32 v5, v5, v165, v166
v_or_b32 v5, v5, v167
v_and_b32 v5, 7, v5
v_cmp_ne_u32 vcc, 0, v5
s_cbranch_vccz L_gb_c0
s_bitset1_b32 s46, 0
buffer_load_dwordx4 v[160:163], v17, s[40:43], s98 offen offset:0 sc1
buffer_load_dwordx4 v[164:167], v17, s[40:43], s98 offen offset:1024 sc1
L_gb_c0:
v_or3_b32 v5, v168, v169, v170
v_or3_b32 v5, v5, v171, v172
v_or3_b32 v5, v5, v173, v174
v_or_b32 v5, v5, v175
v_and_b32 v5, 7, v5
v_cmp_ne_u32 vcc, 0, v5
s_cbranch_vccz L_gb_c1
s_bitset1_b32 s46, 1
buffer_load_dwordx4 v[168:171], v17, s[40:43], s99 offen offset:0 sc1
buffer_load_dwordx4 v[172:175], v17, s[40:43], s99 offen offset:1024 sc1
L_gb_c1:
v_or3_b32 v5, v176, v177, v178
v_or3_b32 v5, v5, v179, v180
v_or3_b32 v5, v5, v181, v182
v_or_b32 v5, v5, v183
v_and_b32 v5, 7, v5
v_cmp_ne_u32 vcc, 0, v5
s_cbranch_vccz L_gb_c2
s_bitset1_b32 s46, 2
buffer_load_dwordx4 v[176:179], v17, s[40:43], s100 offen offset:0 sc1
buffer_load_dwordx4 v[180:183], v17, s[40:43], s100 offen offset:1024 sc1
L_gb_c2:
v_or3_b32 v5, v184, v185, v186
v_or3_b32 v5, v5, v187, v188
v_or3_b32 v5, v5, v189, v190
v_or_b32 v5, v5, v191
v_and_b32 v5, 7, v5
v_cmp_ne_u32 vcc, 0, v5
s_cbranch_vccz L_gb_c3
s_bitset1_b32 s46, 3
buffer_load_dwordx4 v[184:187], v17, s[40:43], s101 offen offset:0 sc1
buffer_load_dwordx4 v[188:191], v17, s[40:43], s101 offen offset:1024 sc1
L_gb_c3:
v_or3_b32 v5, v192, v193, v194
v_or_b32 v5, v5, v195
v_and_b32 v5, 7, v5
v_cmp_ne_u32 vcc, 0, v5
s_cbranch_vccz L_gb_c4
s_bitset1_b32 s46, 4
buffer_load_dwordx4 v[192:195], v148, s[40:43], s3 offen sc1
L_gb_c4:
s_cmp_eq_u32 s46, 0
s_cbranch_scc1 L_gb_done
s_add_u32 s68, s68, 1
s_waitcnt vmcnt(0)
s_bitcmp1_b32 s46, 0
s_cbranch_scc0 L_gb_u0
v_xor_b32 v160, v144, v160
v_xor_b32 v161, v145, v161
v_xor_b32 v162, v146, v162
v_xor_b32 v163, v147, v163
v_xor_b32 v164, v144, v164
v_xor_b32 v165, v145, v165
v_xor_b32 v166, v146, v166
v_xor_b32 v167, v147, v167
L_gb_u0:
s_bitcmp1_b32 s46, 1
s_cbranch_scc0 L_gb_u1
v_xor_b32 v168, v144, v168
v_xor_b32 v169, v145, v169
v_xor_b32 v170, v146, v170
v_xor_b32 v171, v147, v171
v_xor_b32 v172, v144, v172
v_xor_b32 v173, v145, v173
v_xor_b32 v174, v146, v174
v_xor_b32 v175, v147, v175
L_gb_u1:
s_bitcmp1_b32 s46, 2
s_cbranch_scc0 L_gb_u2
v_xor_b32 v176, v144, v176
v_xor_b32 v177, v145, v177
v_xor_b32 v178, v146, v178
v_xor_b32 v179, v147, v179
v_xor_b32 v180, v144, v180
v_xor_b32 v181, v145, v181
v_xor_b32 v182, v146, v182
v_xor_b32 v183, v147, v183
L_gb_u2:
s_bitcmp1_b32 s46, 3
s_cbranch_scc0 L_gb_u3
v_xor_b32 v184, v144, v184
v_xor_b32 v185, v145, v185
v_xor_b32 v186, v146, v186
v_xor_b32 v187, v147, v187
v_xor_b32 v188, v144, v188
v_xor_b32 v189, v145, v189
v_xor_b32 v190, v146, v190
v_xor_b32 v191, v147, v191
L_gb_u3:
s_bitcmp1_b32 s46, 4
s_cbranch_scc0 L_gb_u4
v_xor_b32 v192, v200, v192
v_xor_b32 v193, v201, v193
v_xor_b32 v194, v202, v194
v_xor_b32 v195, v203, v195
L_gb_u4:
s_cmp_lt_u32 s68, 1000000
s_cbranch_scc1 L_gb_loop
s_branch L_gb_done
L_bump:
v_mov_b32 v6, s44
s_mov_b64 exec, 1
buffer_store_dword v6, off, s[40:43], s15 sc1
s_mov_b64 exec, -1
s_branch L_bumped
L_idb:
s_mov_b32 s61, 3
L_idrb:
s_lshl_b32 s51, s49, 4
buffer_load_dwordx4 v[128:131], off, s[92:95], s51 sc1
s_waitcnt vmcnt(0)
v_xor_b32 v128, s1, v128
v_xor_b32 v129, s1, v129
v_xor_b32 v130, s1, v130
v_xor_b32 v131, s1, v131
v_or3_b32 v5, v128, v129, v130
v_or_b32 v5, v5, v131
v_cmp_ne_u32 vcc, 0, v5
s_cbranch_vccz L_iddb
s_sub_u32 s61, s61, 1
s_cmp_lg_u32 s61, 0
s_cbranch_scc1 L_idrb
s_mov_b32 s0, 0
s_branch L_iddb
L_ppb_r:
buffer_store_dwordx4 v[116:119], v158, s[40:43], s19 offen sc1
s_branch L_ppb_d
L_kp_r:
buffer_store_dwordx4 v[120:123], v17, s[40:43], s97 offen sc1
s_branch L_kp_d
L_zp_r:
buffer_store_dwordx4 v[116:119], v148, s[40:43], s51 offen sc1
s_branch L_zp_d
L_code_end:
.fill 64, 4, 0xbf810000
.section .rodata,"a"
.p2align 6
.amdhsa_kernel standalone__linear_kernel_rfa__prompt_kernel
  .amdhsa_next_free_vgpr 256
  .amdhsa_next_free_sgpr 102
  .amdhsa_accum_offset 256
  .amdhsa_group_segment_fixed_size 0
  .amdhsa_kernarg_size 56
  .amdhsa_user_sgpr_count 2
  .amdhsa_user_sgpr_kernarg_segment_ptr 1
  .amdhsa_system_sgpr_workgroup_id_x 1
  .amdhsa_float_denorm_mode_32 3
.end_amdhsa_kernel
```
